```python
import torch

def _softmax(x, axis=-1):
    return torch.softmax(x, dim=axis)
def _gelu(x):
    return torch.nn.functional.gelu(x, approximate="tanh")
def _silu(x):
    return torch.nn.functional.silu(x)
def _sigmoid(x):
    return torch.sigmoid(x)
def _layernorm(x, axis=-1, eps=1e-5):
    m = x.mean(dim=axis, keepdim=True)
    v = x.var(dim=axis, keepdim=True, unbiased=False)
    return (x - m) / torch.sqrt(v + eps)
def _scatter_add(tgt, idx, src, axis=0):
    return tgt.clone().index_add_(axis, idx, src)
def _segment_sum(src, seg, n):
    out = torch.zeros((n,) + src.shape[1:], dtype=src.dtype)
    return out.index_add_(0, seg, src)
def _pad(x, pw):
    flat = tuple(v for pair in reversed(pw) for v in pair)
    return torch.nn.functional.pad(x, flat)

kernel_name = 'standalone__paged_block_table_kv_pagedattention__decode'

def setup_inputs():

    _w = (lambda a: (lambda t: t.to(torch.bfloat16) if t.is_floating_point() else t)(torch.as_tensor(a)))
    B, Hq, Hkv, Sq, Skv, D = 2, 32, 16, 1, 8192, 128
    bs = 16
    nbps = max(1, Skv // bs)
    num_phys = B * nbps + 4
    bt = torch.randperm(num_phys)[: B * nbps].reshape(B, nbps).to(torch.int64)
    cl = (nbps * bs - (torch.arange(1, B + 1, dtype=torch.int64) * 2654435761) % max(1, nbps * bs // 2)).to(torch.int64)
    return {
        "q": _w((lambda *s: torch.randn(*s, dtype=torch.bfloat16) * 0.8)(B, Hq, Sq, D)),
        "k_cache": _w((lambda *s: torch.randn(*s, dtype=torch.bfloat16) * 0.8)(num_phys, bs, Hkv, D)),
        "v_cache": _w((lambda *s: torch.randn(*s, dtype=torch.bfloat16) * 0.05)(num_phys, bs, Hkv, D)),
        "block_table": _w(bt),
        "context_lens": _w(cl),
    }

def reference(q, k_cache, v_cache, block_table, context_lens):
    B, Hq, Sq, D = q.shape
    bs = k_cache.shape[1]
    Hkv = k_cache.shape[2]
    nbps = block_table.shape[1]
    Skv = nbps * bs
    bt = block_table.reshape(-1)
    k = (lambda x, *d: x.permute(*d))(k_cache[bt].reshape(B, Skv, Hkv, D), 0, 2, 1, 3)
    v = (lambda x, *d: x.permute(*d))(v_cache[bt].reshape(B, Skv, Hkv, D), 0, 2, 1, 3)
    g = Hq // Hkv
    qg = q.reshape(B, Hkv, g, Sq, D)
    scores = torch.einsum("bhgqd,bhkd->bhgqk", qg, k) * (D ** -0.5)
    pos = torch.arange(Skv)
    msk = pos[None, :] < context_lens[:, None]
    scores = torch.where(msk[:, None, None, None, :], scores, -1e9)
    p = _softmax(scores, axis=-1)
    out = torch.einsum("bhgqk,bhkd->bhgqd", p, v)
    return out.reshape(B, Hq, Sq, D)
```

```asm
; @launch grid=(256,1,1) block=(512,1,1) lds=68096
.amdgcn_target "amdgcn-amd-amdhsa--gfx950"
.text
.globl standalone__paged_block_table_kv_pagedattention__decode_kernel
.p2align 8
.type standalone__paged_block_table_kv_pagedattention__decode_kernel,@function
standalone__paged_block_table_kv_pagedattention__decode_kernel:
    s_cmp_ge_u32 s2, 256
    s_cbranch_scc1 L_end
    s_load_dwordx16 s[4:19], s[0:1], 0
    v_mov_b32 v16, 0
    v_mov_b32 v17, 0
    v_mov_b32 v18, 0
    v_mov_b32 v19, 0
    ds_write_b128 v16, v[16:19] offset:384
    v_lshrrev_b32 v1, 6, v0
    v_and_b32 v0, 63, v0
    v_readfirstlane_b32 s3, v1
    s_lshr_b32 s22, s2, 3
    s_and_b32 s75, s22, 7
    s_lshr_b32 s23, s2, 6
    s_lshl_b32 s23, s23, 3
    s_and_b32 s24, s2, 7
    s_or_b32 s23, s23, s24
    s_lshr_b32 s21, s3, 2
    s_and_b32 s20, s3, 3
    s_xor_b32 s22, s75, s21
    s_mul_i32 s24, s21, 31
    s_xor_b32 s23, s23, s24
    s_lshl_b32 s25, s20, 5
    s_add_u32 s25, s25, s23
    s_lshl_b32 s27, s21, 9
    s_add_u32 s27, s27, s25
    s_lshl_b32 s27, s27, 2
    v_lshrrev_b32 v2, 5, v0
    v_and_b32 v3, 31, v0
    v_lshlrev_b32 v1, 12, v2
    v_lshl_add_u32 v1, v3, 4, v1
    s_lshl_b32 s26, s22, 9
    v_add_u32 v1, s26, v1
    v_bfe_u32 v4, v0, 4, 1
    v_and_b32 v5, 1, v0
    v_lshl_add_u32 v6, v4, 1, v5
    v_and_b32 v7, 15, v0
    v_lshlrev_b32 v8, 8, v6
    v_lshl_add_u32 v14, v7, 4, v8
    v_xor_b32 v15, 16, v14
    s_lshl_b32 s28, s21, 3
    s_add_u32 s28, s28, s22
    s_lshl_b32 s31, s28, 10
    s_waitcnt lgkmcnt(0)
    s_add_u32 s10, s10, s27
    s_addc_u32 s11, s11, 0
    s_load_dword s56, s[10:11], 0
    s_load_dword s57, s[10:11], 512
    s_load_dword s58, s[10:11], 1024
    s_load_dword s59, s[10:11], 1536
    s_load_dwordx2 s[66:67], s[12:13], 0
    s_barrier
    s_mov_b32 s40, s4
    s_mov_b32 s41, s5
    s_mov_b32 s42, 16384
    s_mov_b32 s43, 0x20000
    buffer_load_dwordx4 v[80:83], v14, s[40:43], s31 offen
    buffer_load_dwordx4 v[84:87], v15, s[40:43], s31 offen
    s_mov_b32 s32, s6
    s_mov_b32 s33, s7
    s_mov_b32 s34, 67371008
    s_mov_b32 s35, 0x20000
    s_mov_b32 s36, s8
    s_mov_b32 s37, s9
    s_mov_b32 s38, 67371008
    s_mov_b32 s39, 0x20000
    s_lshl_b32 s30, s25, 4
    s_cmp_eq_u32 s21, 0
    s_waitcnt lgkmcnt(0)
    s_cselect_b32 s29, s66, s67
    s_cmp_lt_i32 s29, 1
    s_cselect_b32 s68, 1, 0
    s_cselect_b32 s29, 8192, s29
    s_min_i32 s29, s29, 8192
    s_sub_i32 s60, s29, s30
    s_lshl_b32 s56, s56, 16
    s_cmp_gt_i32 s60, 0
    s_cselect_b32 s56, s56, 0x7f000000
    buffer_load_dwordx4 v[96:99], v1, s[32:35], s56 offen nt
    s_add_u32 s30, s56, 8192
    buffer_load_dwordx4 v[100:103], v1, s[32:35], s30 offen nt
    s_add_u32 s30, s56, 16384
    buffer_load_dwordx4 v[104:107], v1, s[32:35], s30 offen nt
    s_add_u32 s30, s56, 24576
    buffer_load_dwordx4 v[108:111], v1, s[32:35], s30 offen nt
    s_add_u32 s30, s56, 32768
    buffer_load_dwordx4 v[112:115], v1, s[32:35], s30 offen nt
    s_add_u32 s30, s56, 40960
    buffer_load_dwordx4 v[116:119], v1, s[32:35], s30 offen nt
    s_add_u32 s30, s56, 49152
    buffer_load_dwordx4 v[120:123], v1, s[32:35], s30 offen nt
    s_add_u32 s30, s56, 57344
    buffer_load_dwordx4 v[124:127], v1, s[32:35], s30 offen nt
    s_sub_i32 s61, s60, 2048
    s_lshl_b32 s57, s57, 16
    s_cmp_gt_i32 s61, 0
    s_cselect_b32 s57, s57, 0x7f000000
    buffer_load_dwordx4 v[128:131], v1, s[32:35], s57 offen nt
    s_add_u32 s30, s57, 8192
    buffer_load_dwordx4 v[132:135], v1, s[32:35], s30 offen nt
    s_add_u32 s30, s57, 16384
    buffer_load_dwordx4 v[136:139], v1, s[32:35], s30 offen nt
    s_add_u32 s30, s57, 24576
    buffer_load_dwordx4 v[140:143], v1, s[32:35], s30 offen nt
    s_add_u32 s30, s57, 32768
    buffer_load_dwordx4 v[144:147], v1, s[32:35], s30 offen nt
    s_add_u32 s30, s57, 40960
    buffer_load_dwordx4 v[148:151], v1, s[32:35], s30 offen nt
    s_add_u32 s30, s57, 49152
    buffer_load_dwordx4 v[152:155], v1, s[32:35], s30 offen nt
    s_add_u32 s30, s57, 57344
    buffer_load_dwordx4 v[156:159], v1, s[32:35], s30 offen nt
    s_mov_b32 s44, s18
    s_mov_b32 s45, s19
    s_mov_b32 s46, 4194304
    s_mov_b32 s47, 0x20000
    s_mov_b32 s48, s14
    s_mov_b32 s49, s15
    s_mov_b32 s50, 16384
    s_mov_b32 s51, 0x20000
    s_mov_b32 s52, s16
    s_mov_b32 s53, s17
    s_mov_b32 s54, 256
    s_mov_b32 s55, 0x20000
    s_mov_b32 s64, 0x05040100
    s_mov_b32 s65, 0x07060302
    s_mov_b32 s69, 0x3e0293ee
    v_bfe_u32 v8, v0, 2, 2
    v_lshl_add_u32 v10, v8, 1, v2
    v_add_u32 v9, 8, v10
    v_mov_b32 v13, 0xff800000
    v_bfe_u32 v11, v0, 1, 1
    v_cmp_eq_u32 vcc, v11, v4
    v_and_b32 v12, 1, v8
    v_lshlrev_b32 v12, 4, v12
    v_mov_b32 v11, 0xffff
    v_lshlrev_b32 v12, v12, v11
    v_cndmask_b32 v12, 0, v12, vcc
    v_cmp_gt_u32 vcc, 2, v8
    v_mov_b32 v32, 0
    v_mov_b32 v33, 0
    v_mov_b32 v34, 0
    v_mov_b32 v35, 0
    v_mov_b32 v36, 0
    v_mov_b32 v37, 0
    v_mov_b32 v38, 0
    v_mov_b32 v39, 0
    v_mov_b32 v40, 0
    v_mov_b32 v41, 0
    v_mov_b32 v42, 0
    v_mov_b32 v43, 0
    v_mov_b32 v44, 0
    v_mov_b32 v45, 0
    v_mov_b32 v46, 0
    v_mov_b32 v47, 0
    v_mov_b32 v48, 0
    v_mov_b32 v49, 0
    v_mov_b32 v50, 0
    v_mov_b32 v51, 0
    v_mov_b32 v52, 0
    v_mov_b32 v53, 0
    v_mov_b32 v54, 0
    v_mov_b32 v55, 0
    v_mov_b32 v56, 0
    v_mov_b32 v57, 0
    v_mov_b32 v58, 0
    v_mov_b32 v59, 0
    v_mov_b32 v60, 0
    v_mov_b32 v61, 0
    v_mov_b32 v62, 0
    v_mov_b32 v63, 0
    v_cndmask_b32 v11, 0, v12, vcc
    v_cndmask_b32 v12, v12, 0, vcc
    v_mov_b32 v24, v13
    v_mov_b32 v25, v13
    v_mov_b32 v26, v13
    v_mov_b32 v27, v13
    v_mov_b32 v28, v13
    v_mov_b32 v29, v13
    v_mov_b32 v30, v13
    v_mov_b32 v31, v13
    v_mov_b32 v92, 0
    s_lshl_b32 s30, s21, 2
    v_add_u32 v93, s30, v6
    s_lshl_b32 s30, s20, 2
    v_lshlrev_b32 v94, 4, v93
    v_add_u32 v94, s30, v94
    s_lshl_b32 s30, s20, 3
    v_lshlrev_b32 v93, 5, v93
    v_lshl_add_u32 v93, v2, 2, v93
    v_add_u32 v93, s30, v93
    s_sub_i32 s62, s60, 4096
    s_lshl_b32 s58, s58, 16
    s_cmp_gt_i32 s62, 0
    s_cselect_b32 s58, s58, 0x7f000000
    buffer_load_dwordx4 v[160:163], v1, s[32:35], s58 offen nt
    s_add_u32 s30, s58, 8192
    buffer_load_dwordx4 v[164:167], v1, s[32:35], s30 offen nt
    s_add_u32 s30, s58, 16384
    buffer_load_dwordx4 v[168:171], v1, s[32:35], s30 offen nt
    s_add_u32 s30, s58, 24576
    buffer_load_dwordx4 v[172:175], v1, s[32:35], s30 offen nt
    s_add_u32 s30, s58, 32768
    buffer_load_dwordx4 v[176:179], v1, s[32:35], s30 offen nt
    s_add_u32 s30, s58, 40960
    buffer_load_dwordx4 v[180:183], v1, s[32:35], s30 offen nt
    s_add_u32 s30, s58, 49152
    buffer_load_dwordx4 v[184:187], v1, s[32:35], s30 offen nt
    s_add_u32 s30, s58, 57344
    buffer_load_dwordx4 v[188:191], v1, s[32:35], s30 offen nt
    s_sub_i32 s63, s60, 6144
    s_lshl_b32 s59, s59, 16
    s_cmp_gt_i32 s63, 0
    s_cselect_b32 s59, s59, 0x7f000000
    buffer_load_dwordx4 v[192:195], v1, s[32:35], s59 offen nt
    s_add_u32 s30, s59, 8192
    buffer_load_dwordx4 v[196:199], v1, s[32:35], s30 offen nt
    s_add_u32 s30, s59, 16384
    buffer_load_dwordx4 v[200:203], v1, s[32:35], s30 offen nt
    s_add_u32 s30, s59, 24576
    buffer_load_dwordx4 v[204:207], v1, s[32:35], s30 offen nt
    s_add_u32 s30, s59, 32768
    buffer_load_dwordx4 v[208:211], v1, s[32:35], s30 offen nt
    s_add_u32 s30, s59, 40960
    buffer_load_dwordx4 v[212:215], v1, s[32:35], s30 offen nt
    s_add_u32 s30, s59, 49152
    buffer_load_dwordx4 v[216:219], v1, s[32:35], s30 offen nt
    s_add_u32 s30, s59, 57344
    buffer_load_dwordx4 v[220:223], v1, s[32:35], s30 offen nt
    buffer_load_dwordx4 v[224:227], v1, s[36:39], s56 offen nt
    s_add_u32 s30, s56, 8192
    buffer_load_dwordx4 v[228:231], v1, s[36:39], s30 offen nt
    s_add_u32 s30, s56, 16384
    buffer_load_dwordx4 v[232:235], v1, s[36:39], s30 offen nt
    s_add_u32 s30, s56, 24576
    buffer_load_dwordx4 v[236:239], v1, s[36:39], s30 offen nt
    s_add_u32 s30, s56, 32768
    buffer_load_dwordx4 v[240:243], v1, s[36:39], s30 offen nt
    s_add_u32 s30, s56, 40960
    buffer_load_dwordx4 v[244:247], v1, s[36:39], s30 offen nt
    s_add_u32 s30, s56, 49152
    buffer_load_dwordx4 v[248:251], v1, s[36:39], s30 offen nt
    s_add_u32 s30, s56, 57344
    buffer_load_dwordx4 v[252:255], v1, s[36:39], s30 offen nt
    s_cmp_eq_u32 s68, 0
    s_cbranch_scc1 L_qok
    s_waitcnt vmcnt(40)
    v_mov_b32 v80, 0
    v_mov_b32 v81, 0
    v_mov_b32 v82, 0
    v_mov_b32 v83, 0
    v_mov_b32 v84, 0
    v_mov_b32 v85, 0
    v_mov_b32 v86, 0
    v_mov_b32 v87, 0
L_qok:
    s_cmp_le_i32 s60, 0
    s_cbranch_scc1 L_kskip0
    s_waitcnt vmcnt(36)
    v_dot2_f32_bf16 v16, v96, v80, 0
    v_dot2_f32_bf16 v17, v100, v80, 0
    v_dot2_f32_bf16 v18, v104, v80, 0
    v_dot2_f32_bf16 v19, v108, v80, 0
    v_dot2c_f32_bf16 v16, v97, v81
    v_dot2c_f32_bf16 v17, v101, v81
    v_dot2c_f32_bf16 v18, v105, v81
    v_dot2c_f32_bf16 v19, v109, v81
    v_dot2c_f32_bf16 v16, v98, v82
    v_dot2c_f32_bf16 v17, v102, v82
    v_dot2c_f32_bf16 v18, v106, v82
    v_dot2c_f32_bf16 v19, v110, v82
    v_dot2c_f32_bf16 v16, v99, v83
    v_dot2c_f32_bf16 v17, v103, v83
    v_dot2c_f32_bf16 v18, v107, v83
    v_dot2c_f32_bf16 v19, v111, v83
    v_dot2c_f32_bf16_dpp v16, v96, v84 quad_perm:[1,0,3,2] row_mask:0xf bank_mask:0xf
    v_dot2c_f32_bf16_dpp v17, v100, v84 quad_perm:[1,0,3,2] row_mask:0xf bank_mask:0xf
    v_dot2c_f32_bf16_dpp v18, v104, v84 quad_perm:[1,0,3,2] row_mask:0xf bank_mask:0xf
    v_dot2c_f32_bf16_dpp v19, v108, v84 quad_perm:[1,0,3,2] row_mask:0xf bank_mask:0xf
    v_dot2c_f32_bf16_dpp v16, v97, v85 quad_perm:[1,0,3,2] row_mask:0xf bank_mask:0xf
    v_dot2c_f32_bf16_dpp v17, v101, v85 quad_perm:[1,0,3,2] row_mask:0xf bank_mask:0xf
    v_dot2c_f32_bf16_dpp v18, v105, v85 quad_perm:[1,0,3,2] row_mask:0xf bank_mask:0xf
    v_dot2c_f32_bf16_dpp v19, v109, v85 quad_perm:[1,0,3,2] row_mask:0xf bank_mask:0xf
    v_dot2c_f32_bf16_dpp v16, v98, v86 quad_perm:[1,0,3,2] row_mask:0xf bank_mask:0xf
    v_dot2c_f32_bf16_dpp v17, v102, v86 quad_perm:[1,0,3,2] row_mask:0xf bank_mask:0xf
    v_dot2c_f32_bf16_dpp v18, v106, v86 quad_perm:[1,0,3,2] row_mask:0xf bank_mask:0xf
    v_dot2c_f32_bf16_dpp v19, v110, v86 quad_perm:[1,0,3,2] row_mask:0xf bank_mask:0xf
    v_dot2c_f32_bf16_dpp v16, v99, v87 quad_perm:[1,0,3,2] row_mask:0xf bank_mask:0xf
    v_dot2c_f32_bf16_dpp v17, v103, v87 quad_perm:[1,0,3,2] row_mask:0xf bank_mask:0xf
    v_dot2c_f32_bf16_dpp v18, v107, v87 quad_perm:[1,0,3,2] row_mask:0xf bank_mask:0xf
    v_dot2c_f32_bf16_dpp v19, v111, v87 quad_perm:[1,0,3,2] row_mask:0xf bank_mask:0xf
    s_waitcnt vmcnt(32)
    v_dot2_f32_bf16 v20, v112, v80, 0
    v_dot2_f32_bf16 v21, v116, v80, 0
    v_dot2_f32_bf16 v22, v120, v80, 0
    v_dot2_f32_bf16 v23, v124, v80, 0
    v_dot2c_f32_bf16 v20, v113, v81
    v_dot2c_f32_bf16 v21, v117, v81
    v_dot2c_f32_bf16 v22, v121, v81
    v_dot2c_f32_bf16 v23, v125, v81
    v_dot2c_f32_bf16 v20, v114, v82
    v_dot2c_f32_bf16 v21, v118, v82
    v_dot2c_f32_bf16 v22, v122, v82
    v_dot2c_f32_bf16 v23, v126, v82
    v_dot2c_f32_bf16 v20, v115, v83
    v_dot2c_f32_bf16 v21, v119, v83
    v_dot2c_f32_bf16 v22, v123, v83
    v_dot2c_f32_bf16 v23, v127, v83
    v_dot2c_f32_bf16_dpp v20, v112, v84 quad_perm:[1,0,3,2] row_mask:0xf bank_mask:0xf
    v_dot2c_f32_bf16_dpp v21, v116, v84 quad_perm:[1,0,3,2] row_mask:0xf bank_mask:0xf
    v_dot2c_f32_bf16_dpp v22, v120, v84 quad_perm:[1,0,3,2] row_mask:0xf bank_mask:0xf
    v_dot2c_f32_bf16_dpp v23, v124, v84 quad_perm:[1,0,3,2] row_mask:0xf bank_mask:0xf
    v_dot2c_f32_bf16_dpp v20, v113, v85 quad_perm:[1,0,3,2] row_mask:0xf bank_mask:0xf
    v_dot2c_f32_bf16_dpp v21, v117, v85 quad_perm:[1,0,3,2] row_mask:0xf bank_mask:0xf
    v_dot2c_f32_bf16_dpp v22, v121, v85 quad_perm:[1,0,3,2] row_mask:0xf bank_mask:0xf
    v_dot2c_f32_bf16_dpp v23, v125, v85 quad_perm:[1,0,3,2] row_mask:0xf bank_mask:0xf
    v_dot2c_f32_bf16_dpp v20, v114, v86 quad_perm:[1,0,3,2] row_mask:0xf bank_mask:0xf
    v_dot2c_f32_bf16_dpp v21, v118, v86 quad_perm:[1,0,3,2] row_mask:0xf bank_mask:0xf
    v_dot2c_f32_bf16_dpp v22, v122, v86 quad_perm:[1,0,3,2] row_mask:0xf bank_mask:0xf
    v_dot2c_f32_bf16_dpp v23, v126, v86 quad_perm:[1,0,3,2] row_mask:0xf bank_mask:0xf
    v_dot2c_f32_bf16_dpp v20, v115, v87 quad_perm:[1,0,3,2] row_mask:0xf bank_mask:0xf
    v_dot2c_f32_bf16_dpp v21, v119, v87 quad_perm:[1,0,3,2] row_mask:0xf bank_mask:0xf
    v_dot2c_f32_bf16_dpp v22, v123, v87 quad_perm:[1,0,3,2] row_mask:0xf bank_mask:0xf
    v_dot2c_f32_bf16_dpp v23, v127, v87 quad_perm:[1,0,3,2] row_mask:0xf bank_mask:0xf
    v_add_f32_dpp v64, v16, v16 row_ror:8 row_mask:0xf bank_mask:0x3
    v_add_f32_dpp v64, v18, v18 row_ror:8 row_mask:0xf bank_mask:0xc
    v_add_f32_dpp v65, v17, v17 row_ror:8 row_mask:0xf bank_mask:0x3
    v_add_f32_dpp v65, v19, v19 row_ror:8 row_mask:0xf bank_mask:0xc
    v_add_f32_dpp v66, v20, v20 row_ror:8 row_mask:0xf bank_mask:0x3
    v_add_f32_dpp v66, v22, v22 row_ror:8 row_mask:0xf bank_mask:0xc
    v_add_f32_dpp v67, v21, v21 row_ror:8 row_mask:0xf bank_mask:0x3
    v_add_f32_dpp v67, v23, v23 row_ror:8 row_mask:0xf bank_mask:0xc
    v_add_f32_dpp v68, v64, v64 row_shl:4 row_mask:0xf bank_mask:0x5
    v_add_f32_dpp v68, v65, v65 row_shr:4 row_mask:0xf bank_mask:0xa
    v_add_f32_dpp v69, v66, v66 row_shl:4 row_mask:0xf bank_mask:0x5
    v_add_f32_dpp v69, v67, v67 row_shr:4 row_mask:0xf bank_mask:0xa
    v_cmp_gt_i32 vcc, s60, v10
    v_cmp_gt_i32 s[70:71], s60, v9
    v_add_f32_dpp v68, v68, v68 quad_perm:[2,3,0,1] row_mask:0xf bank_mask:0xf
    v_add_f32_dpp v69, v69, v69 quad_perm:[2,3,0,1] row_mask:0xf bank_mask:0xf
    v_cndmask_b32 v24, v13, v68, vcc
    v_cndmask_b32 v25, v13, v69, s[70:71]
L_kskip0:
    s_waitcnt vmcnt(32)
    buffer_load_dwordx4 v[96:99], v1, s[36:39], s57 offen nt
    s_add_u32 s30, s57, 8192
    buffer_load_dwordx4 v[100:103], v1, s[36:39], s30 offen nt
    s_add_u32 s30, s57, 16384
    buffer_load_dwordx4 v[104:107], v1, s[36:39], s30 offen nt
    s_add_u32 s30, s57, 24576
    buffer_load_dwordx4 v[108:111], v1, s[36:39], s30 offen nt
    s_add_u32 s30, s57, 32768
    buffer_load_dwordx4 v[112:115], v1, s[36:39], s30 offen nt
    s_add_u32 s30, s57, 40960
    buffer_load_dwordx4 v[116:119], v1, s[36:39], s30 offen nt
    s_add_u32 s30, s57, 49152
    buffer_load_dwordx4 v[120:123], v1, s[36:39], s30 offen nt
    s_add_u32 s30, s57, 57344
    buffer_load_dwordx4 v[124:127], v1, s[36:39], s30 offen nt
    s_cmp_le_i32 s61, 0
    s_cbranch_scc1 L_kskip1
    s_waitcnt vmcnt(36)
    v_dot2_f32_bf16 v16, v128, v80, 0
    v_dot2_f32_bf16 v17, v132, v80, 0
    v_dot2_f32_bf16 v18, v136, v80, 0
    v_dot2_f32_bf16 v19, v140, v80, 0
    v_dot2c_f32_bf16 v16, v129, v81
    v_dot2c_f32_bf16 v17, v133, v81
    v_dot2c_f32_bf16 v18, v137, v81
    v_dot2c_f32_bf16 v19, v141, v81
    v_dot2c_f32_bf16 v16, v130, v82
    v_dot2c_f32_bf16 v17, v134, v82
    v_dot2c_f32_bf16 v18, v138, v82
    v_dot2c_f32_bf16 v19, v142, v82
    v_dot2c_f32_bf16 v16, v131, v83
    v_dot2c_f32_bf16 v17, v135, v83
    v_dot2c_f32_bf16 v18, v139, v83
    v_dot2c_f32_bf16 v19, v143, v83
    v_dot2c_f32_bf16_dpp v16, v128, v84 quad_perm:[1,0,3,2] row_mask:0xf bank_mask:0xf
    v_dot2c_f32_bf16_dpp v17, v132, v84 quad_perm:[1,0,3,2] row_mask:0xf bank_mask:0xf
    v_dot2c_f32_bf16_dpp v18, v136, v84 quad_perm:[1,0,3,2] row_mask:0xf bank_mask:0xf
    v_dot2c_f32_bf16_dpp v19, v140, v84 quad_perm:[1,0,3,2] row_mask:0xf bank_mask:0xf
    v_dot2c_f32_bf16_dpp v16, v129, v85 quad_perm:[1,0,3,2] row_mask:0xf bank_mask:0xf
    v_dot2c_f32_bf16_dpp v17, v133, v85 quad_perm:[1,0,3,2] row_mask:0xf bank_mask:0xf
    v_dot2c_f32_bf16_dpp v18, v137, v85 quad_perm:[1,0,3,2] row_mask:0xf bank_mask:0xf
    v_dot2c_f32_bf16_dpp v19, v141, v85 quad_perm:[1,0,3,2] row_mask:0xf bank_mask:0xf
    v_dot2c_f32_bf16_dpp v16, v130, v86 quad_perm:[1,0,3,2] row_mask:0xf bank_mask:0xf
    v_dot2c_f32_bf16_dpp v17, v134, v86 quad_perm:[1,0,3,2] row_mask:0xf bank_mask:0xf
    v_dot2c_f32_bf16_dpp v18, v138, v86 quad_perm:[1,0,3,2] row_mask:0xf bank_mask:0xf
    v_dot2c_f32_bf16_dpp v19, v142, v86 quad_perm:[1,0,3,2] row_mask:0xf bank_mask:0xf
    v_dot2c_f32_bf16_dpp v16, v131, v87 quad_perm:[1,0,3,2] row_mask:0xf bank_mask:0xf
    v_dot2c_f32_bf16_dpp v17, v135, v87 quad_perm:[1,0,3,2] row_mask:0xf bank_mask:0xf
    v_dot2c_f32_bf16_dpp v18, v139, v87 quad_perm:[1,0,3,2] row_mask:0xf bank_mask:0xf
    v_dot2c_f32_bf16_dpp v19, v143, v87 quad_perm:[1,0,3,2] row_mask:0xf bank_mask:0xf
    s_waitcnt vmcnt(32)
    v_dot2_f32_bf16 v20, v144, v80, 0
    v_dot2_f32_bf16 v21, v148, v80, 0
    v_dot2_f32_bf16 v22, v152, v80, 0
    v_dot2_f32_bf16 v23, v156, v80, 0
    v_dot2c_f32_bf16 v20, v145, v81
    v_dot2c_f32_bf16 v21, v149, v81
    v_dot2c_f32_bf16 v22, v153, v81
    v_dot2c_f32_bf16 v23, v157, v81
    v_dot2c_f32_bf16 v20, v146, v82
    v_dot2c_f32_bf16 v21, v150, v82
    v_dot2c_f32_bf16 v22, v154, v82
    v_dot2c_f32_bf16 v23, v158, v82
    v_dot2c_f32_bf16 v20, v147, v83
    v_dot2c_f32_bf16 v21, v151, v83
    v_dot2c_f32_bf16 v22, v155, v83
    v_dot2c_f32_bf16 v23, v159, v83
    v_dot2c_f32_bf16_dpp v20, v144, v84 quad_perm:[1,0,3,2] row_mask:0xf bank_mask:0xf
    v_dot2c_f32_bf16_dpp v21, v148, v84 quad_perm:[1,0,3,2] row_mask:0xf bank_mask:0xf
    v_dot2c_f32_bf16_dpp v22, v152, v84 quad_perm:[1,0,3,2] row_mask:0xf bank_mask:0xf
    v_dot2c_f32_bf16_dpp v23, v156, v84 quad_perm:[1,0,3,2] row_mask:0xf bank_mask:0xf
    v_dot2c_f32_bf16_dpp v20, v145, v85 quad_perm:[1,0,3,2] row_mask:0xf bank_mask:0xf
    v_dot2c_f32_bf16_dpp v21, v149, v85 quad_perm:[1,0,3,2] row_mask:0xf bank_mask:0xf
    v_dot2c_f32_bf16_dpp v22, v153, v85 quad_perm:[1,0,3,2] row_mask:0xf bank_mask:0xf
    v_dot2c_f32_bf16_dpp v23, v157, v85 quad_perm:[1,0,3,2] row_mask:0xf bank_mask:0xf
    v_dot2c_f32_bf16_dpp v20, v146, v86 quad_perm:[1,0,3,2] row_mask:0xf bank_mask:0xf
    v_dot2c_f32_bf16_dpp v21, v150, v86 quad_perm:[1,0,3,2] row_mask:0xf bank_mask:0xf
    v_dot2c_f32_bf16_dpp v22, v154, v86 quad_perm:[1,0,3,2] row_mask:0xf bank_mask:0xf
    v_dot2c_f32_bf16_dpp v23, v158, v86 quad_perm:[1,0,3,2] row_mask:0xf bank_mask:0xf
    v_dot2c_f32_bf16_dpp v20, v147, v87 quad_perm:[1,0,3,2] row_mask:0xf bank_mask:0xf
    v_dot2c_f32_bf16_dpp v21, v151, v87 quad_perm:[1,0,3,2] row_mask:0xf bank_mask:0xf
    v_dot2c_f32_bf16_dpp v22, v155, v87 quad_perm:[1,0,3,2] row_mask:0xf bank_mask:0xf
    v_dot2c_f32_bf16_dpp v23, v159, v87 quad_perm:[1,0,3,2] row_mask:0xf bank_mask:0xf
    v_add_f32_dpp v64, v16, v16 row_ror:8 row_mask:0xf bank_mask:0x3
    v_add_f32_dpp v64, v18, v18 row_ror:8 row_mask:0xf bank_mask:0xc
    v_add_f32_dpp v65, v17, v17 row_ror:8 row_mask:0xf bank_mask:0x3
    v_add_f32_dpp v65, v19, v19 row_ror:8 row_mask:0xf bank_mask:0xc
    v_add_f32_dpp v66, v20, v20 row_ror:8 row_mask:0xf bank_mask:0x3
    v_add_f32_dpp v66, v22, v22 row_ror:8 row_mask:0xf bank_mask:0xc
    v_add_f32_dpp v67, v21, v21 row_ror:8 row_mask:0xf bank_mask:0x3
    v_add_f32_dpp v67, v23, v23 row_ror:8 row_mask:0xf bank_mask:0xc
    v_add_f32_dpp v68, v64, v64 row_shl:4 row_mask:0xf bank_mask:0x5
    v_add_f32_dpp v68, v65, v65 row_shr:4 row_mask:0xf bank_mask:0xa
    v_add_f32_dpp v69, v66, v66 row_shl:4 row_mask:0xf bank_mask:0x5
    v_add_f32_dpp v69, v67, v67 row_shr:4 row_mask:0xf bank_mask:0xa
    v_cmp_gt_i32 vcc, s61, v10
    v_cmp_gt_i32 s[70:71], s61, v9
    v_add_f32_dpp v68, v68, v68 quad_perm:[2,3,0,1] row_mask:0xf bank_mask:0xf
    v_add_f32_dpp v69, v69, v69 quad_perm:[2,3,0,1] row_mask:0xf bank_mask:0xf
    v_cndmask_b32 v26, v13, v68, vcc
    v_cndmask_b32 v27, v13, v69, s[70:71]
L_kskip1:
    s_waitcnt vmcnt(32)
    buffer_load_dwordx4 v[128:131], v1, s[36:39], s58 offen nt
    s_add_u32 s30, s58, 8192
    buffer_load_dwordx4 v[132:135], v1, s[36:39], s30 offen nt
    s_add_u32 s30, s58, 16384
    buffer_load_dwordx4 v[136:139], v1, s[36:39], s30 offen nt
    s_add_u32 s30, s58, 24576
    buffer_load_dwordx4 v[140:143], v1, s[36:39], s30 offen nt
    s_add_u32 s30, s58, 32768
    buffer_load_dwordx4 v[144:147], v1, s[36:39], s30 offen nt
    s_add_u32 s30, s58, 40960
    buffer_load_dwordx4 v[148:151], v1, s[36:39], s30 offen nt
    s_add_u32 s30, s58, 49152
    buffer_load_dwordx4 v[152:155], v1, s[36:39], s30 offen nt
    s_add_u32 s30, s58, 57344
    buffer_load_dwordx4 v[156:159], v1, s[36:39], s30 offen nt
    s_cmp_le_i32 s62, 0
    s_cbranch_scc1 L_kskip2
    s_waitcnt vmcnt(36)
    v_dot2_f32_bf16 v16, v160, v80, 0
    v_dot2_f32_bf16 v17, v164, v80, 0
    v_dot2_f32_bf16 v18, v168, v80, 0
    v_dot2_f32_bf16 v19, v172, v80, 0
    v_dot2c_f32_bf16 v16, v161, v81
    v_dot2c_f32_bf16 v17, v165, v81
    v_dot2c_f32_bf16 v18, v169, v81
    v_dot2c_f32_bf16 v19, v173, v81
    v_dot2c_f32_bf16 v16, v162, v82
    v_dot2c_f32_bf16 v17, v166, v82
    v_dot2c_f32_bf16 v18, v170, v82
    v_dot2c_f32_bf16 v19, v174, v82
    v_dot2c_f32_bf16 v16, v163, v83
    v_dot2c_f32_bf16 v17, v167, v83
    v_dot2c_f32_bf16 v18, v171, v83
    v_dot2c_f32_bf16 v19, v175, v83
    v_dot2c_f32_bf16_dpp v16, v160, v84 quad_perm:[1,0,3,2] row_mask:0xf bank_mask:0xf
    v_dot2c_f32_bf16_dpp v17, v164, v84 quad_perm:[1,0,3,2] row_mask:0xf bank_mask:0xf
    v_dot2c_f32_bf16_dpp v18, v168, v84 quad_perm:[1,0,3,2] row_mask:0xf bank_mask:0xf
    v_dot2c_f32_bf16_dpp v19, v172, v84 quad_perm:[1,0,3,2] row_mask:0xf bank_mask:0xf
    v_dot2c_f32_bf16_dpp v16, v161, v85 quad_perm:[1,0,3,2] row_mask:0xf bank_mask:0xf
    v_dot2c_f32_bf16_dpp v17, v165, v85 quad_perm:[1,0,3,2] row_mask:0xf bank_mask:0xf
    v_dot2c_f32_bf16_dpp v18, v169, v85 quad_perm:[1,0,3,2] row_mask:0xf bank_mask:0xf
    v_dot2c_f32_bf16_dpp v19, v173, v85 quad_perm:[1,0,3,2] row_mask:0xf bank_mask:0xf
    v_dot2c_f32_bf16_dpp v16, v162, v86 quad_perm:[1,0,3,2] row_mask:0xf bank_mask:0xf
    v_dot2c_f32_bf16_dpp v17, v166, v86 quad_perm:[1,0,3,2] row_mask:0xf bank_mask:0xf
    v_dot2c_f32_bf16_dpp v18, v170, v86 quad_perm:[1,0,3,2] row_mask:0xf bank_mask:0xf
    v_dot2c_f32_bf16_dpp v19, v174, v86 quad_perm:[1,0,3,2] row_mask:0xf bank_mask:0xf
    v_dot2c_f32_bf16_dpp v16, v163, v87 quad_perm:[1,0,3,2] row_mask:0xf bank_mask:0xf
    v_dot2c_f32_bf16_dpp v17, v167, v87 quad_perm:[1,0,3,2] row_mask:0xf bank_mask:0xf
    v_dot2c_f32_bf16_dpp v18, v171, v87 quad_perm:[1,0,3,2] row_mask:0xf bank_mask:0xf
    v_dot2c_f32_bf16_dpp v19, v175, v87 quad_perm:[1,0,3,2] row_mask:0xf bank_mask:0xf
    s_waitcnt vmcnt(32)
    v_dot2_f32_bf16 v20, v176, v80, 0
    v_dot2_f32_bf16 v21, v180, v80, 0
    v_dot2_f32_bf16 v22, v184, v80, 0
    v_dot2_f32_bf16 v23, v188, v80, 0
    v_dot2c_f32_bf16 v20, v177, v81
    v_dot2c_f32_bf16 v21, v181, v81
    v_dot2c_f32_bf16 v22, v185, v81
    v_dot2c_f32_bf16 v23, v189, v81
    v_dot2c_f32_bf16 v20, v178, v82
    v_dot2c_f32_bf16 v21, v182, v82
    v_dot2c_f32_bf16 v22, v186, v82
    v_dot2c_f32_bf16 v23, v190, v82
    v_dot2c_f32_bf16 v20, v179, v83
    v_dot2c_f32_bf16 v21, v183, v83
    v_dot2c_f32_bf16 v22, v187, v83
    v_dot2c_f32_bf16 v23, v191, v83
    v_dot2c_f32_bf16_dpp v20, v176, v84 quad_perm:[1,0,3,2] row_mask:0xf bank_mask:0xf
    v_dot2c_f32_bf16_dpp v21, v180, v84 quad_perm:[1,0,3,2] row_mask:0xf bank_mask:0xf
    v_dot2c_f32_bf16_dpp v22, v184, v84 quad_perm:[1,0,3,2] row_mask:0xf bank_mask:0xf
    v_dot2c_f32_bf16_dpp v23, v188, v84 quad_perm:[1,0,3,2] row_mask:0xf bank_mask:0xf
    v_dot2c_f32_bf16_dpp v20, v177, v85 quad_perm:[1,0,3,2] row_mask:0xf bank_mask:0xf
    v_dot2c_f32_bf16_dpp v21, v181, v85 quad_perm:[1,0,3,2] row_mask:0xf bank_mask:0xf
    v_dot2c_f32_bf16_dpp v22, v185, v85 quad_perm:[1,0,3,2] row_mask:0xf bank_mask:0xf
    v_dot2c_f32_bf16_dpp v23, v189, v85 quad_perm:[1,0,3,2] row_mask:0xf bank_mask:0xf
    v_dot2c_f32_bf16_dpp v20, v178, v86 quad_perm:[1,0,3,2] row_mask:0xf bank_mask:0xf
    v_dot2c_f32_bf16_dpp v21, v182, v86 quad_perm:[1,0,3,2] row_mask:0xf bank_mask:0xf
    v_dot2c_f32_bf16_dpp v22, v186, v86 quad_perm:[1,0,3,2] row_mask:0xf bank_mask:0xf
    v_dot2c_f32_bf16_dpp v23, v190, v86 quad_perm:[1,0,3,2] row_mask:0xf bank_mask:0xf
    v_dot2c_f32_bf16_dpp v20, v179, v87 quad_perm:[1,0,3,2] row_mask:0xf bank_mask:0xf
    v_dot2c_f32_bf16_dpp v21, v183, v87 quad_perm:[1,0,3,2] row_mask:0xf bank_mask:0xf
    v_dot2c_f32_bf16_dpp v22, v187, v87 quad_perm:[1,0,3,2] row_mask:0xf bank_mask:0xf
    v_dot2c_f32_bf16_dpp v23, v191, v87 quad_perm:[1,0,3,2] row_mask:0xf bank_mask:0xf
    v_add_f32_dpp v64, v16, v16 row_ror:8 row_mask:0xf bank_mask:0x3
    v_add_f32_dpp v64, v18, v18 row_ror:8 row_mask:0xf bank_mask:0xc
    v_add_f32_dpp v65, v17, v17 row_ror:8 row_mask:0xf bank_mask:0x3
    v_add_f32_dpp v65, v19, v19 row_ror:8 row_mask:0xf bank_mask:0xc
    v_add_f32_dpp v66, v20, v20 row_ror:8 row_mask:0xf bank_mask:0x3
    v_add_f32_dpp v66, v22, v22 row_ror:8 row_mask:0xf bank_mask:0xc
    v_add_f32_dpp v67, v21, v21 row_ror:8 row_mask:0xf bank_mask:0x3
    v_add_f32_dpp v67, v23, v23 row_ror:8 row_mask:0xf bank_mask:0xc
    v_add_f32_dpp v68, v64, v64 row_shl:4 row_mask:0xf bank_mask:0x5
    v_add_f32_dpp v68, v65, v65 row_shr:4 row_mask:0xf bank_mask:0xa
    v_add_f32_dpp v69, v66, v66 row_shl:4 row_mask:0xf bank_mask:0x5
    v_add_f32_dpp v69, v67, v67 row_shr:4 row_mask:0xf bank_mask:0xa
    v_cmp_gt_i32 vcc, s62, v10
    v_cmp_gt_i32 s[70:71], s62, v9
    v_add_f32_dpp v68, v68, v68 quad_perm:[2,3,0,1] row_mask:0xf bank_mask:0xf
    v_add_f32_dpp v69, v69, v69 quad_perm:[2,3,0,1] row_mask:0xf bank_mask:0xf
    v_cndmask_b32 v28, v13, v68, vcc
    v_cndmask_b32 v29, v13, v69, s[70:71]
L_kskip2:
    s_waitcnt vmcnt(32)
    buffer_load_dwordx4 v[160:163], v1, s[36:39], s59 offen nt
    s_add_u32 s30, s59, 8192
    buffer_load_dwordx4 v[164:167], v1, s[36:39], s30 offen nt
    s_add_u32 s30, s59, 16384
    buffer_load_dwordx4 v[168:171], v1, s[36:39], s30 offen nt
    s_add_u32 s30, s59, 24576
    buffer_load_dwordx4 v[172:175], v1, s[36:39], s30 offen nt
    s_add_u32 s30, s59, 32768
    buffer_load_dwordx4 v[176:179], v1, s[36:39], s30 offen nt
    s_add_u32 s30, s59, 40960
    buffer_load_dwordx4 v[180:183], v1, s[36:39], s30 offen nt
    s_add_u32 s30, s59, 49152
    buffer_load_dwordx4 v[184:187], v1, s[36:39], s30 offen nt
    s_add_u32 s30, s59, 57344
    buffer_load_dwordx4 v[188:191], v1, s[36:39], s30 offen nt
    s_cmp_le_i32 s63, 0
    s_cbranch_scc1 L_kskip3
    s_waitcnt vmcnt(36)
    v_dot2_f32_bf16 v16, v192, v80, 0
    v_dot2_f32_bf16 v17, v196, v80, 0
    v_dot2_f32_bf16 v18, v200, v80, 0
    v_dot2_f32_bf16 v19, v204, v80, 0
    v_dot2c_f32_bf16 v16, v193, v81
    v_dot2c_f32_bf16 v17, v197, v81
    v_dot2c_f32_bf16 v18, v201, v81
    v_dot2c_f32_bf16 v19, v205, v81
    v_dot2c_f32_bf16 v16, v194, v82
    v_dot2c_f32_bf16 v17, v198, v82
    v_dot2c_f32_bf16 v18, v202, v82
    v_dot2c_f32_bf16 v19, v206, v82
    v_dot2c_f32_bf16 v16, v195, v83
    v_dot2c_f32_bf16 v17, v199, v83
    v_dot2c_f32_bf16 v18, v203, v83
    v_dot2c_f32_bf16 v19, v207, v83
    v_dot2c_f32_bf16_dpp v16, v192, v84 quad_perm:[1,0,3,2] row_mask:0xf bank_mask:0xf
    v_dot2c_f32_bf16_dpp v17, v196, v84 quad_perm:[1,0,3,2] row_mask:0xf bank_mask:0xf
    v_dot2c_f32_bf16_dpp v18, v200, v84 quad_perm:[1,0,3,2] row_mask:0xf bank_mask:0xf
    v_dot2c_f32_bf16_dpp v19, v204, v84 quad_perm:[1,0,3,2] row_mask:0xf bank_mask:0xf
    v_dot2c_f32_bf16_dpp v16, v193, v85 quad_perm:[1,0,3,2] row_mask:0xf bank_mask:0xf
    v_dot2c_f32_bf16_dpp v17, v197, v85 quad_perm:[1,0,3,2] row_mask:0xf bank_mask:0xf
    v_dot2c_f32_bf16_dpp v18, v201, v85 quad_perm:[1,0,3,2] row_mask:0xf bank_mask:0xf
    v_dot2c_f32_bf16_dpp v19, v205, v85 quad_perm:[1,0,3,2] row_mask:0xf bank_mask:0xf
    v_dot2c_f32_bf16_dpp v16, v194, v86 quad_perm:[1,0,3,2] row_mask:0xf bank_mask:0xf
    v_dot2c_f32_bf16_dpp v17, v198, v86 quad_perm:[1,0,3,2] row_mask:0xf bank_mask:0xf
    v_dot2c_f32_bf16_dpp v18, v202, v86 quad_perm:[1,0,3,2] row_mask:0xf bank_mask:0xf
    v_dot2c_f32_bf16_dpp v19, v206, v86 quad_perm:[1,0,3,2] row_mask:0xf bank_mask:0xf
    v_dot2c_f32_bf16_dpp v16, v195, v87 quad_perm:[1,0,3,2] row_mask:0xf bank_mask:0xf
    v_dot2c_f32_bf16_dpp v17, v199, v87 quad_perm:[1,0,3,2] row_mask:0xf bank_mask:0xf
    v_dot2c_f32_bf16_dpp v18, v203, v87 quad_perm:[1,0,3,2] row_mask:0xf bank_mask:0xf
    v_dot2c_f32_bf16_dpp v19, v207, v87 quad_perm:[1,0,3,2] row_mask:0xf bank_mask:0xf
    s_waitcnt vmcnt(32)
    v_dot2_f32_bf16 v20, v208, v80, 0
    v_dot2_f32_bf16 v21, v212, v80, 0
    v_dot2_f32_bf16 v22, v216, v80, 0
    v_dot2_f32_bf16 v23, v220, v80, 0
    v_dot2c_f32_bf16 v20, v209, v81
    v_dot2c_f32_bf16 v21, v213, v81
    v_dot2c_f32_bf16 v22, v217, v81
    v_dot2c_f32_bf16 v23, v221, v81
    v_dot2c_f32_bf16 v20, v210, v82
    v_dot2c_f32_bf16 v21, v214, v82
    v_dot2c_f32_bf16 v22, v218, v82
    v_dot2c_f32_bf16 v23, v222, v82
    v_dot2c_f32_bf16 v20, v211, v83
    v_dot2c_f32_bf16 v21, v215, v83
    v_dot2c_f32_bf16 v22, v219, v83
    v_dot2c_f32_bf16 v23, v223, v83
    v_dot2c_f32_bf16_dpp v20, v208, v84 quad_perm:[1,0,3,2] row_mask:0xf bank_mask:0xf
    v_dot2c_f32_bf16_dpp v21, v212, v84 quad_perm:[1,0,3,2] row_mask:0xf bank_mask:0xf
    v_dot2c_f32_bf16_dpp v22, v216, v84 quad_perm:[1,0,3,2] row_mask:0xf bank_mask:0xf
    v_dot2c_f32_bf16_dpp v23, v220, v84 quad_perm:[1,0,3,2] row_mask:0xf bank_mask:0xf
    v_dot2c_f32_bf16_dpp v20, v209, v85 quad_perm:[1,0,3,2] row_mask:0xf bank_mask:0xf
    v_dot2c_f32_bf16_dpp v21, v213, v85 quad_perm:[1,0,3,2] row_mask:0xf bank_mask:0xf
    v_dot2c_f32_bf16_dpp v22, v217, v85 quad_perm:[1,0,3,2] row_mask:0xf bank_mask:0xf
    v_dot2c_f32_bf16_dpp v23, v221, v85 quad_perm:[1,0,3,2] row_mask:0xf bank_mask:0xf
    v_dot2c_f32_bf16_dpp v20, v210, v86 quad_perm:[1,0,3,2] row_mask:0xf bank_mask:0xf
    v_dot2c_f32_bf16_dpp v21, v214, v86 quad_perm:[1,0,3,2] row_mask:0xf bank_mask:0xf
    v_dot2c_f32_bf16_dpp v22, v218, v86 quad_perm:[1,0,3,2] row_mask:0xf bank_mask:0xf
    v_dot2c_f32_bf16_dpp v23, v222, v86 quad_perm:[1,0,3,2] row_mask:0xf bank_mask:0xf
    v_dot2c_f32_bf16_dpp v20, v211, v87 quad_perm:[1,0,3,2] row_mask:0xf bank_mask:0xf
    v_dot2c_f32_bf16_dpp v21, v215, v87 quad_perm:[1,0,3,2] row_mask:0xf bank_mask:0xf
    v_dot2c_f32_bf16_dpp v22, v219, v87 quad_perm:[1,0,3,2] row_mask:0xf bank_mask:0xf
    v_dot2c_f32_bf16_dpp v23, v223, v87 quad_perm:[1,0,3,2] row_mask:0xf bank_mask:0xf
    v_add_f32_dpp v64, v16, v16 row_ror:8 row_mask:0xf bank_mask:0x3
    v_add_f32_dpp v64, v18, v18 row_ror:8 row_mask:0xf bank_mask:0xc
    v_add_f32_dpp v65, v17, v17 row_ror:8 row_mask:0xf bank_mask:0x3
    v_add_f32_dpp v65, v19, v19 row_ror:8 row_mask:0xf bank_mask:0xc
    v_add_f32_dpp v66, v20, v20 row_ror:8 row_mask:0xf bank_mask:0x3
    v_add_f32_dpp v66, v22, v22 row_ror:8 row_mask:0xf bank_mask:0xc
    v_add_f32_dpp v67, v21, v21 row_ror:8 row_mask:0xf bank_mask:0x3
    v_add_f32_dpp v67, v23, v23 row_ror:8 row_mask:0xf bank_mask:0xc
    v_add_f32_dpp v68, v64, v64 row_shl:4 row_mask:0xf bank_mask:0x5
    v_add_f32_dpp v68, v65, v65 row_shr:4 row_mask:0xf bank_mask:0xa
    v_add_f32_dpp v69, v66, v66 row_shl:4 row_mask:0xf bank_mask:0x5
    v_add_f32_dpp v69, v67, v67 row_shr:4 row_mask:0xf bank_mask:0xa
    v_cmp_gt_i32 vcc, s63, v10
    v_cmp_gt_i32 s[70:71], s63, v9
    v_add_f32_dpp v68, v68, v68 quad_perm:[2,3,0,1] row_mask:0xf bank_mask:0xf
    v_add_f32_dpp v69, v69, v69 quad_perm:[2,3,0,1] row_mask:0xf bank_mask:0xf
    v_cndmask_b32 v30, v13, v68, vcc
    v_cndmask_b32 v31, v13, v69, s[70:71]
L_kskip3:
    s_waitcnt vmcnt(32)
    v_max3_f32 v64, v24, v25, v26
    v_max3_f32 v65, v27, v28, v29
    v_max3_f32 v64, v64, v30, v31
    v_mov_b32 v66, 0xf149f2ca
    v_max3_f32 v64, v64, v65, v66
    s_nop 1
    v_max_f32_dpp v64, v64, v64 row_ror:4 row_mask:0xf bank_mask:0xf
    s_nop 1
    v_max_f32_dpp v64, v64, v64 row_ror:8 row_mask:0xf bank_mask:0xf
    v_mov_b32 v65, v64
    s_nop 1
    v_permlane32_swap_b32 v64, v65
    v_max_f32 v64, v64, v65
    v_mul_f32 v95, s69, v64
    ds_write_b32 v94, v95 offset:0
    v_fma_f32 v24, v24, s69, -v95
    v_fma_f32 v25, v25, s69, -v95
    v_fma_f32 v26, v26, s69, -v95
    v_fma_f32 v27, v27, s69, -v95
    v_fma_f32 v28, v28, s69, -v95
    v_fma_f32 v29, v29, s69, -v95
    v_fma_f32 v30, v30, s69, -v95
    v_fma_f32 v31, v31, s69, -v95
    v_exp_f32 v24, v24
    v_exp_f32 v25, v25
    v_exp_f32 v26, v26
    v_exp_f32 v27, v27
    v_exp_f32 v28, v28
    v_exp_f32 v29, v29
    v_exp_f32 v30, v30
    v_exp_f32 v31, v31
    v_cvt_pk_bf16_f32 v24, v24, v24
    v_cvt_pk_bf16_f32 v25, v25, v25
    v_cvt_pk_bf16_f32 v26, v26, v26
    v_cvt_pk_bf16_f32 v27, v27, v27
    v_cvt_pk_bf16_f32 v28, v28, v28
    v_cvt_pk_bf16_f32 v29, v29, v29
    v_cvt_pk_bf16_f32 v30, v30, v30
    v_cvt_pk_bf16_f32 v31, v31, v31
    v_and_b32 v16, v24, v11
    v_and_b32 v17, v24, v12
    v_and_b32 v24, 0xffff0000, v24
    v_and_b32 v18, v25, v11
    v_and_b32 v19, v25, v12
    v_and_b32 v25, 0xffff0000, v25
    v_and_b32 v20, v26, v11
    v_and_b32 v21, v26, v12
    v_and_b32 v26, 0xffff0000, v26
    v_and_b32 v22, v27, v11
    v_and_b32 v23, v27, v12
    v_and_b32 v27, 0xffff0000, v27
    v_and_b32 v80, v28, v11
    v_and_b32 v81, v28, v12
    v_and_b32 v28, 0xffff0000, v28
    v_and_b32 v82, v29, v11
    v_and_b32 v83, v29, v12
    v_and_b32 v29, 0xffff0000, v29
    v_and_b32 v84, v30, v11
    v_and_b32 v85, v30, v12
    v_and_b32 v30, 0xffff0000, v30
    v_and_b32 v86, v31, v11
    v_and_b32 v87, v31, v12
    v_and_b32 v31, 0xffff0000, v31
    v_add_f32 v92, v92, v24
    v_add_f32 v92, v92, v25
    v_add_f32 v92, v92, v26
    v_add_f32 v92, v92, v27
    v_add_f32 v92, v92, v28
    v_add_f32 v92, v92, v29
    v_add_f32 v92, v92, v30
    v_add_f32 v92, v92, v31
    s_nop 1
    v_add_f32_dpp v92, v92, v92 row_ror:4 row_mask:0xf bank_mask:0xf
    s_nop 1
    v_add_f32_dpp v92, v92, v92 row_ror:8 row_mask:0xf bank_mask:0xf
    ds_write_b32 v93, v92 offset:128
    s_mul_i32 s30, s3, 8448
    v_mul_u32_u24 v24, 528, v7
    v_lshrrev_b32 v25, 4, v0
    v_lshl_add_u32 v24, v25, 7, v24
    v_add_u32 v24, s30, v24
    v_mul_u32_u24 v25, 16896, v2
    v_lshl_add_u32 v25, v3, 4, v25
    s_lshl_b32 s30, s21, 6
    s_add_u32 s30, s30, s20
    s_mul_i32 s30, s30, 528
    v_add_u32 v25, s30, v25
    s_lshl_b32 s30, s3, 4
    v_mov_b32 v26, s30
    s_lshl_b32 s30, s3, 5
    v_mov_b32 v27, s30
    s_lshl_b32 s30, s28, 5
    s_add_u32 s30, s30, s23
    s_lshl_b32 s30, s30, 2
    s_add_u32 s30, s30, s20
    s_lshl_b32 s72, s30, 9
    s_lshl_b32 s73, s28, 2
    s_add_u32 s73, s73, s20
    s_lshl_b32 s76, s73, 8
    s_lshl_b32 s73, s73, 8
    s_add_u32 s73, s73, 2097152
    s_lshl_b32 s74, s23, 3
    s_add_u32 s74, s74, s73
    v_lshlrev_b32 v28, 4, v3
    v_mov_b32 v29, 0
    v_lshlrev_b32 v30, 3, v3
    v_lshl_add_u32 v31, v2, 11, v28
    v_lshrrev_b32 v88, 3, v3
    v_and_b32 v89, 7, v3
    v_lshl_add_u32 v88, v88, 5, v89
    v_lshlrev_b32 v88, 1, v88
    v_lshlrev_b32 v89, 2, v2
    s_lshl_b32 s77, s28, 7
    s_add_u32 s77, s77, s20
    s_lshl_b32 s77, s77, 9
    s_lshl_b32 s79, s75, 5
    s_cmp_le_i32 s60, 0
    s_cbranch_scc1 L_vdone
    s_waitcnt vmcnt(24)
    v_perm_b32 v64, v228, v224, s64
    v_perm_b32 v65, v236, v232, s64
    v_perm_b32 v66, v244, v240, s64
    v_perm_b32 v67, v252, v248, s64
    v_perm_b32 v68, v228, v224, s65
    v_perm_b32 v69, v236, v232, s65
    v_perm_b32 v70, v244, v240, s65
    v_perm_b32 v71, v252, v248, s65
    v_mfma_f32_16x16x32_bf16 v[32:35], v[64:67], v[16:19], v[32:35]
    v_perm_b32 v72, v229, v225, s64
    v_perm_b32 v73, v237, v233, s64
    v_perm_b32 v74, v245, v241, s64
    v_perm_b32 v75, v253, v249, s64
    v_mfma_f32_16x16x32_bf16 v[36:39], v[68:71], v[16:19], v[36:39]
    v_perm_b32 v76, v229, v225, s65
    v_perm_b32 v77, v237, v233, s65
    v_perm_b32 v78, v245, v241, s65
    v_perm_b32 v79, v253, v249, s65
    v_mfma_f32_16x16x32_bf16 v[40:43], v[72:75], v[16:19], v[40:43]
    v_perm_b32 v64, v230, v226, s64
    v_perm_b32 v65, v238, v234, s64
    v_perm_b32 v66, v246, v242, s64
    v_perm_b32 v67, v254, v250, s64
    v_mfma_f32_16x16x32_bf16 v[44:47], v[76:79], v[16:19], v[44:47]
    v_perm_b32 v68, v230, v226, s65
    v_perm_b32 v69, v238, v234, s65
    v_perm_b32 v70, v246, v242, s65
    v_perm_b32 v71, v254, v250, s65
    v_mfma_f32_16x16x32_bf16 v[48:51], v[64:67], v[16:19], v[48:51]
    v_perm_b32 v72, v231, v227, s64
    v_perm_b32 v73, v239, v235, s64
    v_perm_b32 v74, v247, v243, s64
    v_perm_b32 v75, v255, v251, s64
    v_mfma_f32_16x16x32_bf16 v[52:55], v[68:71], v[16:19], v[52:55]
    v_perm_b32 v76, v231, v227, s65
    v_perm_b32 v77, v239, v235, s65
    v_perm_b32 v78, v247, v243, s65
    v_perm_b32 v79, v255, v251, s65
    v_mfma_f32_16x16x32_bf16 v[56:59], v[72:75], v[16:19], v[56:59]
    s_nop 0
    v_mfma_f32_16x16x32_bf16 v[60:63], v[76:79], v[16:19], v[60:63]
    s_cmp_le_i32 s61, 0
    s_cbranch_scc1 L_vdone
    s_waitcnt vmcnt(16)
    v_perm_b32 v64, v100, v96, s64
    v_perm_b32 v65, v108, v104, s64
    v_perm_b32 v66, v116, v112, s64
    v_perm_b32 v67, v124, v120, s64
    v_perm_b32 v68, v100, v96, s65
    v_perm_b32 v69, v108, v104, s65
    v_perm_b32 v70, v116, v112, s65
    v_perm_b32 v71, v124, v120, s65
    v_mfma_f32_16x16x32_bf16 v[32:35], v[64:67], v[20:23], v[32:35]
    v_perm_b32 v72, v101, v97, s64
    v_perm_b32 v73, v109, v105, s64
    v_perm_b32 v74, v117, v113, s64
    v_perm_b32 v75, v125, v121, s64
    v_mfma_f32_16x16x32_bf16 v[36:39], v[68:71], v[20:23], v[36:39]
    v_perm_b32 v76, v101, v97, s65
    v_perm_b32 v77, v109, v105, s65
    v_perm_b32 v78, v117, v113, s65
    v_perm_b32 v79, v125, v121, s65
    v_mfma_f32_16x16x32_bf16 v[40:43], v[72:75], v[20:23], v[40:43]
    v_perm_b32 v64, v102, v98, s64
    v_perm_b32 v65, v110, v106, s64
    v_perm_b32 v66, v118, v114, s64
    v_perm_b32 v67, v126, v122, s64
    v_mfma_f32_16x16x32_bf16 v[44:47], v[76:79], v[20:23], v[44:47]
    v_perm_b32 v68, v102, v98, s65
    v_perm_b32 v69, v110, v106, s65
    v_perm_b32 v70, v118, v114, s65
    v_perm_b32 v71, v126, v122, s65
    v_mfma_f32_16x16x32_bf16 v[48:51], v[64:67], v[20:23], v[48:51]
    v_perm_b32 v72, v103, v99, s64
    v_perm_b32 v73, v111, v107, s64
    v_perm_b32 v74, v119, v115, s64
    v_perm_b32 v75, v127, v123, s64
    v_mfma_f32_16x16x32_bf16 v[52:55], v[68:71], v[20:23], v[52:55]
    v_perm_b32 v76, v103, v99, s65
    v_perm_b32 v77, v111, v107, s65
    v_perm_b32 v78, v119, v115, s65
    v_perm_b32 v79, v127, v123, s65
    v_mfma_f32_16x16x32_bf16 v[56:59], v[72:75], v[20:23], v[56:59]
    s_nop 0
    v_mfma_f32_16x16x32_bf16 v[60:63], v[76:79], v[20:23], v[60:63]
    s_cmp_le_i32 s62, 0
    s_cbranch_scc1 L_vdone
    s_waitcnt vmcnt(8)
    v_perm_b32 v64, v132, v128, s64
    v_perm_b32 v65, v140, v136, s64
    v_perm_b32 v66, v148, v144, s64
    v_perm_b32 v67, v156, v152, s64
    v_perm_b32 v68, v132, v128, s65
    v_perm_b32 v69, v140, v136, s65
    v_perm_b32 v70, v148, v144, s65
    v_perm_b32 v71, v156, v152, s65
    v_mfma_f32_16x16x32_bf16 v[32:35], v[64:67], v[80:83], v[32:35]
    v_perm_b32 v72, v133, v129, s64
    v_perm_b32 v73, v141, v137, s64
    v_perm_b32 v74, v149, v145, s64
    v_perm_b32 v75, v157, v153, s64
    v_mfma_f32_16x16x32_bf16 v[36:39], v[68:71], v[80:83], v[36:39]
    v_perm_b32 v76, v133, v129, s65
    v_perm_b32 v77, v141, v137, s65
    v_perm_b32 v78, v149, v145, s65
    v_perm_b32 v79, v157, v153, s65
    v_mfma_f32_16x16x32_bf16 v[40:43], v[72:75], v[80:83], v[40:43]
    v_perm_b32 v64, v134, v130, s64
    v_perm_b32 v65, v142, v138, s64
    v_perm_b32 v66, v150, v146, s64
    v_perm_b32 v67, v158, v154, s64
    v_mfma_f32_16x16x32_bf16 v[44:47], v[76:79], v[80:83], v[44:47]
    v_perm_b32 v68, v134, v130, s65
    v_perm_b32 v69, v142, v138, s65
    v_perm_b32 v70, v150, v146, s65
    v_perm_b32 v71, v158, v154, s65
    v_mfma_f32_16x16x32_bf16 v[48:51], v[64:67], v[80:83], v[48:51]
    v_perm_b32 v72, v135, v131, s64
    v_perm_b32 v73, v143, v139, s64
    v_perm_b32 v74, v151, v147, s64
    v_perm_b32 v75, v159, v155, s64
    v_mfma_f32_16x16x32_bf16 v[52:55], v[68:71], v[80:83], v[52:55]
    v_perm_b32 v76, v135, v131, s65
    v_perm_b32 v77, v143, v139, s65
    v_perm_b32 v78, v151, v147, s65
    v_perm_b32 v79, v159, v155, s65
    v_mfma_f32_16x16x32_bf16 v[56:59], v[72:75], v[80:83], v[56:59]
    s_nop 0
    v_mfma_f32_16x16x32_bf16 v[60:63], v[76:79], v[80:83], v[60:63]
    s_cmp_le_i32 s63, 0
    s_cbranch_scc1 L_vdone
    s_waitcnt vmcnt(0)
    v_perm_b32 v64, v164, v160, s64
    v_perm_b32 v65, v172, v168, s64
    v_perm_b32 v66, v180, v176, s64
    v_perm_b32 v67, v188, v184, s64
    v_perm_b32 v68, v164, v160, s65
    v_perm_b32 v69, v172, v168, s65
    v_perm_b32 v70, v180, v176, s65
    v_perm_b32 v71, v188, v184, s65
    v_mfma_f32_16x16x32_bf16 v[32:35], v[64:67], v[84:87], v[32:35]
    v_perm_b32 v72, v165, v161, s64
    v_perm_b32 v73, v173, v169, s64
    v_perm_b32 v74, v181, v177, s64
    v_perm_b32 v75, v189, v185, s64
    v_mfma_f32_16x16x32_bf16 v[36:39], v[68:71], v[84:87], v[36:39]
    v_perm_b32 v76, v165, v161, s65
    v_perm_b32 v77, v173, v169, s65
    v_perm_b32 v78, v181, v177, s65
    v_perm_b32 v79, v189, v185, s65
    v_mfma_f32_16x16x32_bf16 v[40:43], v[72:75], v[84:87], v[40:43]
    v_perm_b32 v64, v166, v162, s64
    v_perm_b32 v65, v174, v170, s64
    v_perm_b32 v66, v182, v178, s64
    v_perm_b32 v67, v190, v186, s64
    v_mfma_f32_16x16x32_bf16 v[44:47], v[76:79], v[84:87], v[44:47]
    v_perm_b32 v68, v166, v162, s65
    v_perm_b32 v69, v174, v170, s65
    v_perm_b32 v70, v182, v178, s65
    v_perm_b32 v71, v190, v186, s65
    v_mfma_f32_16x16x32_bf16 v[48:51], v[64:67], v[84:87], v[48:51]
    v_perm_b32 v72, v167, v163, s64
    v_perm_b32 v73, v175, v171, s64
    v_perm_b32 v74, v183, v179, s64
    v_perm_b32 v75, v191, v187, s64
    v_mfma_f32_16x16x32_bf16 v[52:55], v[68:71], v[84:87], v[52:55]
    v_perm_b32 v76, v167, v163, s65
    v_perm_b32 v77, v175, v171, s65
    v_perm_b32 v78, v183, v179, s65
    v_perm_b32 v79, v191, v187, s65
    v_mfma_f32_16x16x32_bf16 v[56:59], v[72:75], v[84:87], v[56:59]
    s_nop 0
    v_mfma_f32_16x16x32_bf16 v[60:63], v[76:79], v[84:87], v[60:63]
L_vdone:
    s_waitcnt vmcnt(0)
    ds_write_b128 v24, v[32:35] offset:512
    ds_write_b128 v24, v[36:39] offset:528
    ds_write_b128 v24, v[40:43] offset:544
    ds_write_b128 v24, v[44:47] offset:560
    ds_write_b128 v24, v[48:51] offset:576
    ds_write_b128 v24, v[52:55] offset:592
    s_nop 2
    ds_write_b128 v24, v[56:59] offset:608
    ds_write_b128 v24, v[60:63] offset:624
    s_waitcnt lgkmcnt(0)
    s_mov_b32 s78, 1
    s_cmp_lg_u32 s21, 0
    s_cbranch_scc1 L_b1bar
    v_mov_b32 v70, 1
    s_mov_b64 exec, 1
    ds_add_rtn_u32 v70, v29, v70 offset:384
    s_waitcnt lgkmcnt(0)
    v_readfirstlane_b32 s30, v70
    s_mov_b64 exec, -1
    s_cmp_lg_u32 s30, 3
    s_cbranch_scc1 L_bar1
    s_mul_i32 s30, s20, 528
    v_subrev_u32 v25, s30, v25
    s_lshl_b32 s30, s20, 4
    v_subrev_u32 v26, s30, v26
    s_lshl_b32 s30, s20, 5
    v_subrev_u32 v27, s30, v27
    s_lshl_b32 s30, s20, 9
    s_sub_u32 s72, s72, s30
    s_lshl_b32 s30, s20, 8
    s_sub_u32 s74, s74, s30
    s_mov_b32 s78, 4
    s_branch L_merge
L_b1bar:
    s_barrier
L_merge:
    ds_read_b128 v[136:139], v26 offset:0
    ds_read_b128 v[128:131], v27 offset:128
    ds_read_b128 v[132:135], v27 offset:144
    ds_read_b128 v[96:99], v25 offset:512
    ds_read_b128 v[100:103], v25 offset:2624
    ds_read_b128 v[104:107], v25 offset:4736
    ds_read_b128 v[108:111], v25 offset:6848
    ds_read_b128 v[112:115], v25 offset:8960
    ds_read_b128 v[116:119], v25 offset:11072
    ds_read_b128 v[120:123], v25 offset:13184
    ds_read_b128 v[124:127], v25 offset:15296
    s_waitcnt lgkmcnt(10)
    v_max3_f32 v140, v136, v137, v138
    v_max_f32 v140, v140, v139
    v_sub_f32 v136, v136, v140
    v_sub_f32 v137, v137, v140
    v_sub_f32 v138, v138, v140
    v_sub_f32 v139, v139, v140
    v_exp_f32 v136, v136
    v_exp_f32 v137, v137
    v_exp_f32 v138, v138
    v_exp_f32 v139, v139
    s_waitcnt lgkmcnt(8)
    v_add_f32 v128, v128, v129
    v_add_f32 v130, v130, v131
    v_add_f32 v132, v132, v133
    v_add_f32 v134, v134, v135
    v_cmp_eq_u32 vcc, 0, v2
    v_mul_f32 v141, v128, v136
    v_fmac_f32 v141, v130, v137
    v_fmac_f32 v141, v132, v138
    v_fmac_f32 v141, v134, v139
    v_cndmask_b32 v142, v138, v136, vcc
    v_cndmask_b32 v143, v139, v137, vcc
    s_waitcnt lgkmcnt(4)
    v_add_f32 v96, v96, v100
    v_add_f32 v104, v104, v108
    v_add_f32 v97, v97, v101
    v_add_f32 v105, v105, v109
    v_add_f32 v98, v98, v102
    v_add_f32 v106, v106, v110
    v_add_f32 v99, v99, v103
    v_add_f32 v107, v107, v111
    v_add_f32 v96, v96, v104
    v_add_f32 v97, v97, v105
    v_add_f32 v98, v98, v106
    v_add_f32 v99, v99, v107
    s_waitcnt lgkmcnt(0)
    v_add_f32 v112, v112, v116
    v_add_f32 v120, v120, v124
    v_add_f32 v113, v113, v117
    v_add_f32 v121, v121, v125
    v_add_f32 v114, v114, v118
    v_add_f32 v122, v122, v126
    v_add_f32 v115, v115, v119
    v_add_f32 v123, v123, v127
    v_mul_f32 v96, v96, v142
    v_mul_f32 v97, v97, v142
    v_mul_f32 v98, v98, v142
    v_mul_f32 v99, v99, v142
    v_add_f32 v112, v112, v120
    v_add_f32 v113, v113, v121
    v_add_f32 v114, v114, v122
    v_add_f32 v115, v115, v123
    v_fmac_f32 v96, v112, v143
    v_fmac_f32 v97, v113, v143
    v_fmac_f32 v98, v114, v143
    v_fmac_f32 v99, v115, v143
    v_mov_b32 v100, v96
    v_mov_b32 v101, v97
    v_mov_b32 v102, v98
    v_mov_b32 v103, v99
    s_nop 0
    v_permlane32_swap_b32 v96, v100
    v_permlane32_swap_b32 v97, v101
    v_permlane32_swap_b32 v98, v102
    v_permlane32_swap_b32 v99, v103
    v_add_f32 v144, v96, v100
    v_add_f32 v145, v97, v101
    v_add_f32 v146, v98, v102
    v_add_f32 v147, v99, v103
    s_mov_b32 exec_hi, 0
    buffer_store_dwordx4 v[144:147], v28, s[44:47], s72 offen sc1
    s_mov_b64 exec, 1
    buffer_store_dwordx2 v[140:141], v29, s[44:47], s74 offen sc1
    s_mov_b64 exec, -1
    s_sub_u32 s78, s78, 1
    s_cmp_eq_u32 s78, 0
    s_cbranch_scc1 L_mdone
    v_add_u32 v25, 528, v25
    v_add_u32 v26, 16, v26
    v_add_u32 v27, 32, v27
    s_add_u32 s72, s72, 512
    s_add_u32 s74, s74, 256
    s_branch L_merge
L_mdone:
    v_mov_b32 v70, 1
    s_cmp_lg_u32 s21, 0
    s_waitcnt vmcnt(0)
    s_cbranch_scc1 L_b1pub
    s_mov_b64 exec, 1
    buffer_atomic_add v70, v29, s[52:55], s79 offen sc0
    s_mov_b64 exec, -1
    s_waitcnt vmcnt(0)
L_bar1:
    s_barrier
L_spin0:
    s_sleep 6
    ds_read_b32 v70, v29 offset:396
    s_waitcnt lgkmcnt(0)
    v_readfirstlane_b32 s30, v70
    s_cmp_eq_u32 s30, 0
    s_cbranch_scc1 L_spin0
    s_cmp_eq_u32 s30, 1
    s_cbranch_scc1 L_fin
    s_branch L_final
L_b1pub:
    s_mov_b64 exec, 1
    ds_add_rtn_u32 v71, v29, v70 offset:388
    v_mov_b32 v72, 0x100
    s_waitcnt lgkmcnt(0)
    v_readfirstlane_b32 s30, v71
    s_cmp_lg_u32 s30, 3
    s_cbranch_scc1 L_spin
    buffer_atomic_add v72, v29, s[52:55], s79 offen sc0
    s_waitcnt vmcnt(0)
    v_readfirstlane_b32 s30, v72
    s_bfe_u32 s31, s30, 0x80008
    s_cmp_eq_u32 s31, 31
    s_cselect_b32 s31, 2, 1
    v_mov_b32 v70, s31
    ds_write_b32 v29, v70 offset:392
    s_and_b32 s30, s30, 0xffff00ff
    s_mov_b32 s31, 1
    s_cmp_lg_u32 s30, 32
    s_cbranch_scc1 L_noclaim
    v_mov_b32 v72, 0x10000
    buffer_atomic_add v72, v29, s[52:55], s79 offen sc0
    s_waitcnt vmcnt(0)
    v_readfirstlane_b32 s30, v72
    s_lshr_b32 s30, s30, 16
    s_cmp_eq_u32 s30, 0
    s_cselect_b32 s31, 2, 1
L_noclaim:
    v_mov_b32 v73, s31
    ds_write_b32 v29, v73 offset:396
L_spin:
    ds_read_b32 v70, v29 offset:392
    s_waitcnt lgkmcnt(0)
    v_readfirstlane_b32 s30, v70
    s_cmp_eq_u32 s30, 0
    s_cbranch_scc1 L_spin
    s_mov_b64 exec, -1
    s_cmp_lg_u32 s30, 2
    s_cbranch_scc1 L_fin
L_final:
    buffer_load_dwordx2 v[160:161], v30, s[44:47], s73 offen sc1
    buffer_load_dwordx4 v[96:99], v31, s[44:47], s77 offen sc1
    s_add_u32 s77, s77, 4096
    buffer_load_dwordx4 v[100:103], v31, s[44:47], s77 offen sc1
    s_add_u32 s77, s77, 4096
    buffer_load_dwordx4 v[104:107], v31, s[44:47], s77 offen sc1
    s_add_u32 s77, s77, 4096
    buffer_load_dwordx4 v[108:111], v31, s[44:47], s77 offen sc1
    s_add_u32 s77, s77, 4096
    buffer_load_dwordx4 v[112:115], v31, s[44:47], s77 offen sc1
    s_add_u32 s77, s77, 4096
    buffer_load_dwordx4 v[116:119], v31, s[44:47], s77 offen sc1
    s_add_u32 s77, s77, 4096
    buffer_load_dwordx4 v[120:123], v31, s[44:47], s77 offen sc1
    s_add_u32 s77, s77, 4096
    buffer_load_dwordx4 v[124:127], v31, s[44:47], s77 offen sc1
    s_add_u32 s77, s77, 4096
    buffer_load_dwordx4 v[128:131], v31, s[44:47], s77 offen sc1
    s_add_u32 s77, s77, 4096
    buffer_load_dwordx4 v[132:135], v31, s[44:47], s77 offen sc1
    s_add_u32 s77, s77, 4096
    buffer_load_dwordx4 v[136:139], v31, s[44:47], s77 offen sc1
    s_add_u32 s77, s77, 4096
    buffer_load_dwordx4 v[140:143], v31, s[44:47], s77 offen sc1
    s_add_u32 s77, s77, 4096
    buffer_load_dwordx4 v[144:147], v31, s[44:47], s77 offen sc1
    s_add_u32 s77, s77, 4096
    buffer_load_dwordx4 v[148:151], v31, s[44:47], s77 offen sc1
    s_add_u32 s77, s77, 4096
    buffer_load_dwordx4 v[152:155], v31, s[44:47], s77 offen sc1
    s_add_u32 s77, s77, 4096
    buffer_load_dwordx4 v[156:159], v31, s[44:47], s77 offen sc1
    s_waitcnt vmcnt(16)
    v_max_f32_dpp v64, v160, v160 row_ror:1 row_mask:0xf bank_mask:0xf
    s_nop 1
    v_max_f32_dpp v64, v64, v64 row_ror:2 row_mask:0xf bank_mask:0xf
    s_nop 1
    v_max_f32_dpp v64, v64, v64 row_ror:4 row_mask:0xf bank_mask:0xf
    s_nop 1
    v_max_f32_dpp v64, v64, v64 row_ror:8 row_mask:0xf bank_mask:0xf
    v_mov_b32 v65, v64
    s_nop 1
    v_permlane16_swap_b32 v64, v65
    v_max_f32 v64, v64, v65
    v_sub_f32 v160, v160, v64
    v_exp_f32 v160, v160
    s_nop 0
    ds_bpermute_b32 v164, v89, v160 offset:0
    ds_bpermute_b32 v165, v89, v160 offset:8
    ds_bpermute_b32 v166, v89, v160 offset:16
    ds_bpermute_b32 v167, v89, v160 offset:24
    ds_bpermute_b32 v168, v89, v160 offset:32
    ds_bpermute_b32 v169, v89, v160 offset:40
    ds_bpermute_b32 v170, v89, v160 offset:48
    ds_bpermute_b32 v171, v89, v160 offset:56
    ds_bpermute_b32 v172, v89, v160 offset:64
    ds_bpermute_b32 v173, v89, v160 offset:72
    ds_bpermute_b32 v174, v89, v160 offset:80
    ds_bpermute_b32 v175, v89, v160 offset:88
    ds_bpermute_b32 v176, v89, v160 offset:96
    ds_bpermute_b32 v177, v89, v160 offset:104
    ds_bpermute_b32 v178, v89, v160 offset:112
    ds_bpermute_b32 v179, v89, v160 offset:120
    v_mul_f32 v72, v160, v161
    s_nop 1
    v_add_f32_dpp v72, v72, v72 row_ror:1 row_mask:0xf bank_mask:0xf
    s_nop 1
    v_add_f32_dpp v72, v72, v72 row_ror:2 row_mask:0xf bank_mask:0xf
    s_nop 1
    v_add_f32_dpp v72, v72, v72 row_ror:4 row_mask:0xf bank_mask:0xf
    s_nop 1
    v_add_f32_dpp v72, v72, v72 row_ror:8 row_mask:0xf bank_mask:0xf
    v_mov_b32 v73, v72
    s_nop 1
    v_permlane16_swap_b32 v72, v73
    v_add_f32 v72, v72, v73
    v_rcp_f32 v72, v72
    s_waitcnt lgkmcnt(0)
    s_waitcnt vmcnt(15)
    v_mul_f32 v64, v164, v96
    v_mul_f32 v65, v164, v97
    v_mul_f32 v66, v164, v98
    v_mul_f32 v67, v164, v99
    s_waitcnt vmcnt(14)
    v_fmac_f32 v64, v165, v100
    v_fmac_f32 v65, v165, v101
    v_fmac_f32 v66, v165, v102
    v_fmac_f32 v67, v165, v103
    s_waitcnt vmcnt(13)
    v_fmac_f32 v64, v166, v104
    v_fmac_f32 v65, v166, v105
    v_fmac_f32 v66, v166, v106
    v_fmac_f32 v67, v166, v107
    s_waitcnt vmcnt(12)
    v_fmac_f32 v64, v167, v108
    v_fmac_f32 v65, v167, v109
    v_fmac_f32 v66, v167, v110
    v_fmac_f32 v67, v167, v111
    s_waitcnt vmcnt(11)
    v_fmac_f32 v64, v168, v112
    v_fmac_f32 v65, v168, v113
    v_fmac_f32 v66, v168, v114
    v_fmac_f32 v67, v168, v115
    s_waitcnt vmcnt(10)
    v_fmac_f32 v64, v169, v116
    v_fmac_f32 v65, v169, v117
    v_fmac_f32 v66, v169, v118
    v_fmac_f32 v67, v169, v119
    s_waitcnt vmcnt(9)
    v_fmac_f32 v64, v170, v120
    v_fmac_f32 v65, v170, v121
    v_fmac_f32 v66, v170, v122
    v_fmac_f32 v67, v170, v123
    s_waitcnt vmcnt(8)
    v_fmac_f32 v64, v171, v124
    v_fmac_f32 v65, v171, v125
    v_fmac_f32 v66, v171, v126
    v_fmac_f32 v67, v171, v127
    s_waitcnt vmcnt(7)
    v_fmac_f32 v64, v172, v128
    v_fmac_f32 v65, v172, v129
    v_fmac_f32 v66, v172, v130
    v_fmac_f32 v67, v172, v131
    s_waitcnt vmcnt(6)
    v_fmac_f32 v64, v173, v132
    v_fmac_f32 v65, v173, v133
    v_fmac_f32 v66, v173, v134
    v_fmac_f32 v67, v173, v135
    s_waitcnt vmcnt(5)
    v_fmac_f32 v64, v174, v136
    v_fmac_f32 v65, v174, v137
    v_fmac_f32 v66, v174, v138
    v_fmac_f32 v67, v174, v139
    s_waitcnt vmcnt(4)
    v_fmac_f32 v64, v175, v140
    v_fmac_f32 v65, v175, v141
    v_fmac_f32 v66, v175, v142
    v_fmac_f32 v67, v175, v143
    s_waitcnt vmcnt(3)
    v_fmac_f32 v64, v176, v144
    v_fmac_f32 v65, v176, v145
    v_fmac_f32 v66, v176, v146
    v_fmac_f32 v67, v176, v147
    s_waitcnt vmcnt(2)
    v_fmac_f32 v64, v177, v148
    v_fmac_f32 v65, v177, v149
    v_fmac_f32 v66, v177, v150
    v_fmac_f32 v67, v177, v151
    s_waitcnt vmcnt(1)
    v_fmac_f32 v64, v178, v152
    v_fmac_f32 v65, v178, v153
    v_fmac_f32 v66, v178, v154
    v_fmac_f32 v67, v178, v155
    s_waitcnt vmcnt(0)
    v_fmac_f32 v64, v179, v156
    v_fmac_f32 v65, v179, v157
    v_fmac_f32 v66, v179, v158
    v_fmac_f32 v67, v179, v159
    v_mov_b32 v76, v64
    v_mov_b32 v77, v65
    v_mov_b32 v78, v66
    v_mov_b32 v79, v67
    s_nop 0
    v_permlane32_swap_b32 v64, v76
    v_permlane32_swap_b32 v65, v77
    v_permlane32_swap_b32 v66, v78
    v_permlane32_swap_b32 v67, v79
    v_add_f32 v64, v64, v76
    v_add_f32 v65, v65, v77
    v_add_f32 v66, v66, v78
    v_add_f32 v67, v67, v79
    v_mul_f32 v64, v64, v72
    v_mul_f32 v65, v65, v72
    v_mul_f32 v66, v66, v72
    v_mul_f32 v67, v67, v72
    v_cvt_pk_bf16_f32 v64, v64, v65
    v_cvt_pk_bf16_f32 v66, v66, v67
    s_mov_b32 exec_hi, 0
    buffer_store_short v64, v88, s[48:51], s76 offen
    buffer_store_short_d16_hi v64, v88, s[48:51], s76 offen offset:16
    buffer_store_short v66, v88, s[48:51], s76 offen offset:32
    buffer_store_short_d16_hi v66, v88, s[48:51], s76 offen offset:48
    s_mov_b64 exec, -1
L_fin:
L_end:
    s_endpgm
.section .rodata,"a"
.p2align 6
.amdhsa_kernel standalone__paged_block_table_kv_pagedattention__decode_kernel
  .amdhsa_next_free_vgpr 256
  .amdhsa_next_free_sgpr 100
  .amdhsa_accum_offset 256
  .amdhsa_group_segment_fixed_size 0
  .amdhsa_kernarg_size 64
  .amdhsa_user_sgpr_count 2
  .amdhsa_user_sgpr_kernarg_segment_ptr 1
  .amdhsa_system_sgpr_workgroup_id_x 1
.end_amdhsa_kernel
```
